```python
import torch

def _softmax(x, axis=-1):
    return torch.softmax(x, dim=axis)
def _gelu(x):
    return torch.nn.functional.gelu(x, approximate="tanh")
def _silu(x):
    return torch.nn.functional.silu(x)
def _sigmoid(x):
    return torch.sigmoid(x)
def _layernorm(x, axis=-1, eps=1e-5):
    m = x.mean(dim=axis, keepdim=True)
    v = x.var(dim=axis, keepdim=True, unbiased=False)
    return (x - m) / torch.sqrt(v + eps)
def _scatter_add(tgt, idx, src, axis=0):
    return tgt.clone().index_add_(axis, idx, src)
def _segment_sum(src, seg, n):
    out = torch.zeros((n,) + src.shape[1:], dtype=src.dtype)
    return out.index_add_(0, seg, src)
def _pad(x, pw):
    flat = tuple(v for pair in reversed(pw) for v in pair)
    return torch.nn.functional.pad(x, flat)

kernel_name = 'standalone__linear_kernel_rfa__sampling'

def setup_inputs():

    _w = (lambda a: (lambda t: t.to(torch.bfloat16) if t.is_floating_point() else t)(torch.as_tensor(a)))
    B, H, Sq, Sk, D, M = 8, 32, 32, 2048, 128, 8
    return {
        "q": _w((lambda *s: torch.randn(*s, dtype=torch.bfloat16) * 0.05)(B, H, Sq, D)),
        "k": _w((lambda *s: torch.randn(*s, dtype=torch.bfloat16) * 0.4)(B, H, Sk, D)),
        "v": _w((lambda *s: torch.randn(*s, dtype=torch.bfloat16) * 0.4)(B, H, Sk, D)),
        "omega": _w((lambda *s: torch.randn(*s, dtype=torch.bfloat16) * 0.8)(M, D)),
    }

def reference(q, k, v, omega):
    d = q.shape[-1]
    m = omega.shape[0]
    scale = float(d) ** -0.25
    qs = q * scale
    ks = k * scale
    q_proj = torch.einsum("bhsd,md->bhsm", qs, omega)
    k_proj = torch.einsum("bhsd,md->bhsm", ks, omega)
    q_sq = 0.5 * torch.einsum("bhsd,bhsd->bhs", qs, qs)[..., None]
    k_sq = 0.5 * torch.einsum("bhsd,bhsd->bhs", ks, ks)[..., None]
    inv_sqrt_m = float(m) ** -0.5
    phi_q = torch.exp(q_proj - q_sq) * inv_sqrt_m + 1e-6
    phi_k = torch.exp(k_proj - k_sq) * inv_sqrt_m + 1e-6
    kv = torch.einsum("bhsm,bhsd->bhmd", phi_k, v)
    z  = torch.einsum("bhsm->bhm", phi_k)
    num = torch.einsum("bhqm,bhmd->bhqd", phi_q, kv)
    den = torch.einsum("bhqm,bhm->bhq", phi_q, z)[..., None] + 1e-6
    return num / den
```

```asm
; @launch grid=(256,1,1) block=(256,1,1) lds=100096
.amdgcn_target "amdgcn-amd-amdhsa--gfx950"
.text
.globl standalone__linear_kernel_rfa__sampling_kernel
.p2align 8
.type standalone__linear_kernel_rfa__sampling_kernel,@function
standalone__linear_kernel_rfa__sampling_kernel:
s_cmp_ge_u32 s2, 256
s_cbranch_scc1 L_end
s_load_dwordx8 s[4:11], s[0:1], 0
s_getpc_b64 s[76:77]
L_pc:
v_lshlrev_b32 v3, 7, v0
v_min_u32 v3, L_codeend-L_pc-4, v3
global_load_dword v144, v3, s[76:77]
s_load_dwordx2 s[12:13], s[0:1], 32
v_lshrrev_b32 v1, 6, v0
v_and_b32 v2, 63, v0
v_lshrrev_b32 v4, 4, v2
v_bfe_u32 v6, v2, 2, 2
v_readfirstlane_b32 s47, v1
v_and_b32 v5, 3, v2
v_lshlrev_b32 v5, 4, v5
v_lshl_add_u32 v5, v4, 6, v5
v_lshl_add_u32 v10, v6, 8, v5
v_lshl_add_u32 v10, v1, 12, v10
v_lshlrev_b32 v5, 4, v2
v_and_b32 v7, 0x7f, v0
v_lshlrev_b32 v7, 4, v7
v_lshl_add_u32 v8, v1, 11, v5
s_mov_b32 s50, 32768
s_mov_b32 s51, 4096
s_mov_b32 s52, 36864
s_mov_b32 s53, 8192
s_mov_b32 s54, 40960
s_mov_b32 s55, 12288
s_mov_b32 s56, 45056
s_mov_b32 s58, 65536
s_and_b32 s22, s2, 0x38
s_lshr_b32 s22, s22, 3
s_and_b32 s3, s2, 0xc0
s_lshr_b32 s3, s3, 1
s_or_b32 s22, s22, s3
s_and_b32 s3, s2, 0x6
s_lshl_b32 s3, s3, 2
s_or_b32 s22, s22, s3
s_and_b32 s3, s2, 0x1
s_lshl_b32 s3, s3, 7
s_or_b32 s22, s22, s3
s_lshl_b32 s3, s22, 19
s_lshl_b32 s22, s22, 13
s_mov_b32 s18, 524288
s_mov_b32 s19, 0x20000
s_mov_b32 s30, 2048
s_mov_b32 s31, 0x20000
s_mov_b32 s26, 8192
s_mov_b32 s27, 0x20000
s_waitcnt lgkmcnt(0)
s_mov_b32 s28, s10
s_mov_b32 s29, s11
buffer_load_dwordx4 v[72:75], v7, s[28:31], 0 offen
s_add_u32 s24, s4, s22
s_addc_u32 s25, s5, 0
s_add_u32 s16, s6, s3
s_addc_u32 s17, s7, 0
s_add_u32 s20, s8, s3
s_addc_u32 s21, s9, 0
s_add_u32 s32, s12, s22
s_addc_u32 s33, s13, 0
s_mov_b32 s34, 8192
s_mov_b32 s35, 0x20000
v_and_b32 v3, 15, v2
v_bfe_u32 v136, v0, 4, 3
buffer_load_dwordx4 v[76:79], v8, s[24:27], 0 offen offset:0 nt
v_mul_u32_u24 v136, 272, v136
v_lshl_add_u32 v136, v3, 4, v136
v_lshl_add_u32 v137, v1, 3, v4
v_mul_u32_u24 v137, 272, v137
v_lshl_add_u32 v137, v3, 4, v137
v_and_b32 v9, 7, v2
v_mul_u32_u24 v9, 272, v9
v_lshl_add_u32 v9, v4, 6, v9
v_mul_u32_u24 v188, 272, v3
v_lshl_add_u32 v188, v4, 6, v188
v_add_u32 v188, 91392, v188
v_add_u32 v136, 89216, v136
buffer_load_dwordx4 v[80:83], v8, s[24:27], 0 offen offset:1024 nt
v_add_u32 v9, 89216, v9
v_add_u32 v137, 91392, v137
s_mov_b32 s36, 1048577
s_mov_b32 s37, 268435712
s_mov_b32 s38, 2097154
s_mov_b32 s39, 536871424
s_mov_b32 s40, 4194308
s_mov_b32 s41, 1073742848
s_mov_b32 s42, 8388616
s_mov_b32 s43, 2147485696
s_mov_b32 s44, 0x05040100
s_mov_b32 s45, 0x07060302
buffer_load_dwordx4 v[40:43], v10, s[16:19], 0 offen offset:0 nt
s_mov_b32 s46, 0x3edb9ada
s_mov_b32 s60, 0x55555555
s_mov_b32 s61, 0x55555555
s_mov_b32 s62, 0x33333333
s_mov_b32 s63, 0x33333333
v_mov_b32 v32, 0xbe1837f0
v_mov_b32 v33, 0xbfc00000
v_mov_b32 v28, 0x3f803f80
v_mov_b32 v29, 0x3f803f80
v_mov_b32 v30, 0x3f803f80
v_mov_b32 v31, 0x3f803f80
v_mov_b32 v192, 0
buffer_load_dwordx4 v[44:47], v10, s[16:19], 0 offen offset:1024 nt
v_mov_b32 v193, 0
v_mov_b32 v194, 0
v_mov_b32 v195, 0
v_mov_b32 v196, 0
v_mov_b32 v197, 0
v_mov_b32 v198, 0
v_mov_b32 v199, 0
v_mov_b32 v200, 0
v_mov_b32 v201, 0
v_mov_b32 v202, 0
v_mov_b32 v203, 0
v_mov_b32 v204, 0
buffer_load_dwordx4 v[48:51], v10, s[16:19], 0 offen offset:2048 nt
v_mov_b32 v205, 0
v_mov_b32 v206, 0
v_mov_b32 v207, 0
v_mov_b32 v208, 0
v_mov_b32 v209, 0
v_mov_b32 v210, 0
v_mov_b32 v211, 0
v_mov_b32 v212, 0
v_mov_b32 v213, 0
v_mov_b32 v214, 0
v_mov_b32 v215, 0
v_mov_b32 v216, 0
buffer_load_dwordx4 v[52:55], v10, s[16:19], 0 offen offset:3072 nt
v_mov_b32 v217, 0
v_mov_b32 v218, 0
v_mov_b32 v219, 0
v_mov_b32 v220, 0
v_mov_b32 v221, 0
v_mov_b32 v222, 0
v_mov_b32 v223, 0
v_mov_b32 v224, 0
v_mov_b32 v225, 0
v_mov_b32 v226, 0
v_mov_b32 v227, 0
s_sub_u32 s49, 13, s47
buffer_load_dwordx4 v[56:59], v10, s[16:19], s50 offen offset:0 nt
s_sub_u32 s57, 8, s47
s_mov_b32 s48, 16
v_lshl_add_u32 v11, v1, 12, v5
s_mul_i32 s3, s47, 17408
s_add_u32 s3, s3, 19584
v_add_u32 v38, s3, v5
v_add_u32 v189, 35968, v5
v_lshlrev_b32 v39, 8, v4
v_lshl_add_u32 v39, v1, 6, v39
v_lshl_add_u32 v39, v3, 2, v39
v_add_u32 v39, 475136, v39
buffer_load_dwordx4 v[60:63], v10, s[16:19], s50 offen offset:1024 nt
s_waitcnt vmcnt(6)
ds_write_b128 v136, v[72:75]
ds_write_b128 v137, v[76:79]
ds_write_b128 v137, v[80:83] offset:1088
s_mul_i32 s3, s47, 4896
v_add_u32 v5, s3, v5
v_and_b32 v7, 3, v2
v_mul_u32_u24 v7, 1088, v7
v_lshl_add_u32 v6, v6, 4, v7
v_and_b32 v7, 1, v4
v_lshlrev_b32 v7, 8, v7
v_add_u32 v6, v6, v7
s_lshl_b32 s3, s47, 6
v_add_u32 v6, s3, v6
v_lshlrev_b32 v8, 8, v3
v_lshl_add_u32 v8, v4, 4, v8
v_add_u32 v8, s3, v8
s_waitcnt lgkmcnt(0)
s_barrier
ds_read_b128 v[12:15], v9 offset:0
ds_read_b128 v[16:19], v9 offset:16
ds_read_b128 v[20:23], v9 offset:32
ds_read_b128 v[24:27], v9 offset:48
v_add_u32 v9, 4096, v8
L_kloop:
s_waitcnt vmcnt(5)
buffer_load_dwordx4 v[64:67], v10, s[16:19], s50 offen offset:2048 nt
s_mov_b64 vcc, s[62:63]
v_cndmask_b32_dpp v120, v112, v104, vcc quad_perm:[2,3,0,1] row_mask:0xf bank_mask:0xf
v_cndmask_b32_dpp v121, v113, v105, vcc quad_perm:[2,3,0,1] row_mask:0xf bank_mask:0xf
v_cndmask_b32_dpp v122, v114, v106, vcc quad_perm:[2,3,0,1] row_mask:0xf bank_mask:0xf
v_cndmask_b32_dpp v123, v115, v107, vcc quad_perm:[2,3,0,1] row_mask:0xf bank_mask:0xf
v_cndmask_b32_dpp v124, v116, v108, vcc quad_perm:[2,3,0,1] row_mask:0xf bank_mask:0xf
v_cndmask_b32_dpp v125, v117, v109, vcc quad_perm:[2,3,0,1] row_mask:0xf bank_mask:0xf
v_cndmask_b32_dpp v126, v118, v110, vcc quad_perm:[2,3,0,1] row_mask:0xf bank_mask:0xf
v_cndmask_b32_dpp v127, v119, v111, vcc quad_perm:[2,3,0,1] row_mask:0xf bank_mask:0xf
s_not_b64 vcc, vcc
v_cndmask_b32_dpp v128, v104, v112, vcc quad_perm:[2,3,0,1] row_mask:0xf bank_mask:0xf
v_cndmask_b32_dpp v129, v105, v113, vcc quad_perm:[2,3,0,1] row_mask:0xf bank_mask:0xf
v_mfma_f32_16x16x32_bf16 v[136:139], v[120:123], v[120:123], 0
v_cndmask_b32_dpp v130, v106, v114, vcc quad_perm:[2,3,0,1] row_mask:0xf bank_mask:0xf
v_cndmask_b32_dpp v131, v107, v115, vcc quad_perm:[2,3,0,1] row_mask:0xf bank_mask:0xf
v_mfma_f32_16x16x32_bf16 v[140:143], v[120:123], v[12:15], 0
v_cndmask_b32_dpp v132, v108, v116, vcc quad_perm:[2,3,0,1] row_mask:0xf bank_mask:0xf
v_cndmask_b32_dpp v133, v109, v117, vcc quad_perm:[2,3,0,1] row_mask:0xf bank_mask:0xf
v_mfma_f32_16x16x32_bf16 v[136:139], v[124:127], v[124:127], v[136:139]
v_cndmask_b32_dpp v134, v110, v118, vcc quad_perm:[2,3,0,1] row_mask:0xf bank_mask:0xf
v_cndmask_b32_dpp v135, v111, v119, vcc quad_perm:[2,3,0,1] row_mask:0xf bank_mask:0xf
v_mfma_f32_16x16x32_bf16 v[140:143], v[124:127], v[16:19], v[140:143]
s_waitcnt vmcnt(5)
buffer_load_dwordx4 v[68:71], v10, s[16:19], s50 offen offset:3072 nt
s_cmp_eq_u32 s48, 9
s_cselect_b32 s3, 0xfff94000, s58
v_add_u32 v10, s3, v10
s_cmp_lg_u32 s48, 1
s_cbranch_scc1 L_nosw
s_mov_b32 s16, s20
s_mov_b32 s17, s21
v_mov_b32 v10, v11
L_nosw:
s_mov_b64 vcc, s[60:61]
v_cndmask_b32_dpp v104, v44, v40, vcc quad_perm:[1,0,3,2] row_mask:0xf bank_mask:0xf
v_cndmask_b32_dpp v105, v45, v41, vcc quad_perm:[1,0,3,2] row_mask:0xf bank_mask:0xf
v_mfma_f32_16x16x32_bf16 v[136:139], v[128:131], v[128:131], v[136:139]
v_cndmask_b32_dpp v106, v46, v42, vcc quad_perm:[1,0,3,2] row_mask:0xf bank_mask:0xf
v_cndmask_b32_dpp v107, v47, v43, vcc quad_perm:[1,0,3,2] row_mask:0xf bank_mask:0xf
v_mfma_f32_16x16x32_bf16 v[136:139], v[132:135], v[132:135], v[136:139]
s_not_b64 vcc, vcc
v_cndmask_b32_dpp v108, v40, v44, vcc quad_perm:[1,0,3,2] row_mask:0xf bank_mask:0xf
v_cndmask_b32_dpp v109, v41, v45, vcc quad_perm:[1,0,3,2] row_mask:0xf bank_mask:0xf
v_mfma_f32_16x16x32_bf16 v[140:143], v[128:131], v[20:23], v[140:143]
v_cndmask_b32_dpp v110, v42, v46, vcc quad_perm:[1,0,3,2] row_mask:0xf bank_mask:0xf
v_cndmask_b32_dpp v111, v43, v47, vcc quad_perm:[1,0,3,2] row_mask:0xf bank_mask:0xf
v_mfma_f32_16x16x32_bf16 v[140:143], v[132:135], v[24:27], v[140:143]
s_waitcnt vmcnt(5)
buffer_load_dwordx4 v[40:43], v10, s[16:19], 0 offen offset:0 nt
v_cndmask_b32 v144, 0, v136, s[36:37]
v_cndmask_b32 v144, v144, v137, s[38:39]
v_cndmask_b32 v144, v144, v138, s[40:41]
v_cndmask_b32 v144, v144, v139, s[42:43]
s_nop 1
v_mfma_f32_16x16x4_f32 v[140:143], v144, v32, v[140:143]
s_waitcnt vmcnt(5)
buffer_load_dwordx4 v[44:47], v10, s[16:19], 0 offen offset:1024 nt
s_mov_b64 vcc, s[60:61]
v_cndmask_b32_dpp v112, v52, v48, vcc quad_perm:[1,0,3,2] row_mask:0xf bank_mask:0xf
v_cndmask_b32_dpp v113, v53, v49, vcc quad_perm:[1,0,3,2] row_mask:0xf bank_mask:0xf
v_cndmask_b32_dpp v114, v54, v50, vcc quad_perm:[1,0,3,2] row_mask:0xf bank_mask:0xf
v_cndmask_b32_dpp v115, v55, v51, vcc quad_perm:[1,0,3,2] row_mask:0xf bank_mask:0xf
s_not_b64 vcc, vcc
v_cndmask_b32_dpp v116, v48, v52, vcc quad_perm:[1,0,3,2] row_mask:0xf bank_mask:0xf
v_cndmask_b32_dpp v117, v49, v53, vcc quad_perm:[1,0,3,2] row_mask:0xf bank_mask:0xf
v_cndmask_b32_dpp v118, v50, v54, vcc quad_perm:[1,0,3,2] row_mask:0xf bank_mask:0xf
v_cndmask_b32_dpp v119, v51, v55, vcc quad_perm:[1,0,3,2] row_mask:0xf bank_mask:0xf
v_fma_f32 v140, v140, s46, v33
v_fma_f32 v141, v141, s46, v33
v_fma_f32 v142, v142, s46, v33
v_fma_f32 v143, v143, s46, v33
v_exp_f32 v140, v140
v_exp_f32 v141, v141
v_exp_f32 v142, v142
v_exp_f32 v143, v143
v_add_f32 v140, 0x358637bd, v140
v_add_f32 v141, 0x358637bd, v141
v_add_f32 v142, 0x358637bd, v142
v_add_f32 v143, 0x358637bd, v143
v_cvt_pk_bf16_f32 v150, v140, v141
v_cvt_pk_bf16_f32 v151, v142, v143
s_waitcnt vmcnt(5) lgkmcnt(0)
buffer_load_dwordx4 v[48:51], v10, s[16:19], 0 offen offset:2048 nt
ds_write_b128 v38, v[148:151]
v_add_u32 v38, 1024, v38
s_cmp_eq_u32 s48, 16
s_cbranch_scc1 L_noz
v_mfma_f32_16x16x32_bf16 v[224:227], v[148:151], v[28:31], v[224:227]
L_noz:
s_mov_b64 vcc, s[62:63]
v_cndmask_b32_dpp v120, v112, v104, vcc quad_perm:[2,3,0,1] row_mask:0xf bank_mask:0xf
v_cndmask_b32_dpp v121, v113, v105, vcc quad_perm:[2,3,0,1] row_mask:0xf bank_mask:0xf
v_cndmask_b32_dpp v122, v114, v106, vcc quad_perm:[2,3,0,1] row_mask:0xf bank_mask:0xf
v_cndmask_b32_dpp v123, v115, v107, vcc quad_perm:[2,3,0,1] row_mask:0xf bank_mask:0xf
v_cndmask_b32_dpp v124, v116, v108, vcc quad_perm:[2,3,0,1] row_mask:0xf bank_mask:0xf
v_cndmask_b32_dpp v125, v117, v109, vcc quad_perm:[2,3,0,1] row_mask:0xf bank_mask:0xf
v_cndmask_b32_dpp v126, v118, v110, vcc quad_perm:[2,3,0,1] row_mask:0xf bank_mask:0xf
v_cndmask_b32_dpp v127, v119, v111, vcc quad_perm:[2,3,0,1] row_mask:0xf bank_mask:0xf
s_not_b64 vcc, vcc
v_cndmask_b32_dpp v128, v104, v112, vcc quad_perm:[2,3,0,1] row_mask:0xf bank_mask:0xf
v_cndmask_b32_dpp v129, v105, v113, vcc quad_perm:[2,3,0,1] row_mask:0xf bank_mask:0xf
v_mfma_f32_16x16x32_bf16 v[136:139], v[120:123], v[120:123], 0
v_cndmask_b32_dpp v130, v106, v114, vcc quad_perm:[2,3,0,1] row_mask:0xf bank_mask:0xf
v_cndmask_b32_dpp v131, v107, v115, vcc quad_perm:[2,3,0,1] row_mask:0xf bank_mask:0xf
v_mfma_f32_16x16x32_bf16 v[140:143], v[120:123], v[12:15], 0
v_cndmask_b32_dpp v132, v108, v116, vcc quad_perm:[2,3,0,1] row_mask:0xf bank_mask:0xf
v_cndmask_b32_dpp v133, v109, v117, vcc quad_perm:[2,3,0,1] row_mask:0xf bank_mask:0xf
v_mfma_f32_16x16x32_bf16 v[136:139], v[124:127], v[124:127], v[136:139]
v_cndmask_b32_dpp v134, v110, v118, vcc quad_perm:[2,3,0,1] row_mask:0xf bank_mask:0xf
v_cndmask_b32_dpp v135, v111, v119, vcc quad_perm:[2,3,0,1] row_mask:0xf bank_mask:0xf
v_mfma_f32_16x16x32_bf16 v[140:143], v[124:127], v[16:19], v[140:143]
s_waitcnt vmcnt(5)
buffer_load_dwordx4 v[52:55], v10, s[16:19], 0 offen offset:3072 nt
s_mov_b64 vcc, s[60:61]
v_cndmask_b32_dpp v104, v60, v56, vcc quad_perm:[1,0,3,2] row_mask:0xf bank_mask:0xf
v_cndmask_b32_dpp v105, v61, v57, vcc quad_perm:[1,0,3,2] row_mask:0xf bank_mask:0xf
v_mfma_f32_16x16x32_bf16 v[136:139], v[128:131], v[128:131], v[136:139]
v_cndmask_b32_dpp v106, v62, v58, vcc quad_perm:[1,0,3,2] row_mask:0xf bank_mask:0xf
v_cndmask_b32_dpp v107, v63, v59, vcc quad_perm:[1,0,3,2] row_mask:0xf bank_mask:0xf
v_mfma_f32_16x16x32_bf16 v[136:139], v[132:135], v[132:135], v[136:139]
s_not_b64 vcc, vcc
v_cndmask_b32_dpp v108, v56, v60, vcc quad_perm:[1,0,3,2] row_mask:0xf bank_mask:0xf
v_cndmask_b32_dpp v109, v57, v61, vcc quad_perm:[1,0,3,2] row_mask:0xf bank_mask:0xf
v_mfma_f32_16x16x32_bf16 v[140:143], v[128:131], v[20:23], v[140:143]
v_cndmask_b32_dpp v110, v58, v62, vcc quad_perm:[1,0,3,2] row_mask:0xf bank_mask:0xf
v_cndmask_b32_dpp v111, v59, v63, vcc quad_perm:[1,0,3,2] row_mask:0xf bank_mask:0xf
v_mfma_f32_16x16x32_bf16 v[140:143], v[132:135], v[24:27], v[140:143]
s_waitcnt vmcnt(5)
buffer_load_dwordx4 v[56:59], v10, s[16:19], s50 offen offset:0 nt
v_cndmask_b32 v144, 0, v136, s[36:37]
v_cndmask_b32 v144, v144, v137, s[38:39]
v_cndmask_b32 v144, v144, v138, s[40:41]
v_cndmask_b32 v144, v144, v139, s[42:43]
s_nop 1
v_mfma_f32_16x16x4_f32 v[140:143], v144, v32, v[140:143]
s_waitcnt vmcnt(5)
buffer_load_dwordx4 v[60:63], v10, s[16:19], s50 offen offset:1024 nt
s_mov_b64 vcc, s[60:61]
v_cndmask_b32_dpp v112, v68, v64, vcc quad_perm:[1,0,3,2] row_mask:0xf bank_mask:0xf
v_cndmask_b32_dpp v113, v69, v65, vcc quad_perm:[1,0,3,2] row_mask:0xf bank_mask:0xf
v_cndmask_b32_dpp v114, v70, v66, vcc quad_perm:[1,0,3,2] row_mask:0xf bank_mask:0xf
v_cndmask_b32_dpp v115, v71, v67, vcc quad_perm:[1,0,3,2] row_mask:0xf bank_mask:0xf
s_not_b64 vcc, vcc
v_cndmask_b32_dpp v116, v64, v68, vcc quad_perm:[1,0,3,2] row_mask:0xf bank_mask:0xf
v_cndmask_b32_dpp v117, v65, v69, vcc quad_perm:[1,0,3,2] row_mask:0xf bank_mask:0xf
v_cndmask_b32_dpp v118, v66, v70, vcc quad_perm:[1,0,3,2] row_mask:0xf bank_mask:0xf
v_cndmask_b32_dpp v119, v67, v71, vcc quad_perm:[1,0,3,2] row_mask:0xf bank_mask:0xf
v_fma_f32 v140, v140, s46, v33
v_fma_f32 v141, v141, s46, v33
v_fma_f32 v142, v142, s46, v33
v_fma_f32 v143, v143, s46, v33
v_exp_f32 v140, v140
v_exp_f32 v141, v141
v_exp_f32 v142, v142
v_exp_f32 v143, v143
v_add_f32 v140, 0x358637bd, v140
v_add_f32 v141, 0x358637bd, v141
v_add_f32 v142, 0x358637bd, v142
v_add_f32 v143, 0x358637bd, v143
v_cvt_pk_bf16_f32 v148, v140, v141
v_cvt_pk_bf16_f32 v149, v142, v143
s_sub_u32 s48, s48, 1
s_cmp_lg_u32 s48, 0
s_cbranch_scc1 L_kloop
s_waitcnt vmcnt(4)
buffer_load_dwordx4 v[64:67], v10, s[16:19], s50 offen offset:2048 nt
s_mov_b64 vcc, s[62:63]
v_cndmask_b32_dpp v120, v112, v104, vcc quad_perm:[2,3,0,1] row_mask:0xf bank_mask:0xf
v_cndmask_b32_dpp v121, v113, v105, vcc quad_perm:[2,3,0,1] row_mask:0xf bank_mask:0xf
v_cndmask_b32_dpp v122, v114, v106, vcc quad_perm:[2,3,0,1] row_mask:0xf bank_mask:0xf
v_cndmask_b32_dpp v123, v115, v107, vcc quad_perm:[2,3,0,1] row_mask:0xf bank_mask:0xf
v_cndmask_b32_dpp v124, v116, v108, vcc quad_perm:[2,3,0,1] row_mask:0xf bank_mask:0xf
v_cndmask_b32_dpp v125, v117, v109, vcc quad_perm:[2,3,0,1] row_mask:0xf bank_mask:0xf
v_cndmask_b32_dpp v126, v118, v110, vcc quad_perm:[2,3,0,1] row_mask:0xf bank_mask:0xf
v_cndmask_b32_dpp v127, v119, v111, vcc quad_perm:[2,3,0,1] row_mask:0xf bank_mask:0xf
s_not_b64 vcc, vcc
v_cndmask_b32_dpp v128, v104, v112, vcc quad_perm:[2,3,0,1] row_mask:0xf bank_mask:0xf
v_cndmask_b32_dpp v129, v105, v113, vcc quad_perm:[2,3,0,1] row_mask:0xf bank_mask:0xf
v_cndmask_b32_dpp v130, v106, v114, vcc quad_perm:[2,3,0,1] row_mask:0xf bank_mask:0xf
v_cndmask_b32_dpp v131, v107, v115, vcc quad_perm:[2,3,0,1] row_mask:0xf bank_mask:0xf
v_cndmask_b32_dpp v132, v108, v116, vcc quad_perm:[2,3,0,1] row_mask:0xf bank_mask:0xf
v_cndmask_b32_dpp v133, v109, v117, vcc quad_perm:[2,3,0,1] row_mask:0xf bank_mask:0xf
v_cndmask_b32_dpp v134, v110, v118, vcc quad_perm:[2,3,0,1] row_mask:0xf bank_mask:0xf
v_cndmask_b32_dpp v135, v111, v119, vcc quad_perm:[2,3,0,1] row_mask:0xf bank_mask:0xf
s_waitcnt vmcnt(4)
buffer_load_dwordx4 v[68:71], v10, s[16:19], s50 offen offset:3072 nt
v_add_u32 v10, 65536, v10
v_mfma_f32_16x16x32_bf16 v[136:139], v[120:123], v[120:123], 0
v_mfma_f32_16x16x32_bf16 v[136:139], v[124:127], v[124:127], v[136:139]
v_mfma_f32_16x16x32_bf16 v[136:139], v[128:131], v[128:131], v[136:139]
v_mfma_f32_16x16x32_bf16 v[136:139], v[132:135], v[132:135], v[136:139]
v_mfma_f32_16x16x32_bf16 v[140:143], v[120:123], v[12:15], 0
v_mfma_f32_16x16x32_bf16 v[140:143], v[124:127], v[16:19], v[140:143]
v_mfma_f32_16x16x32_bf16 v[140:143], v[128:131], v[20:23], v[140:143]
v_mfma_f32_16x16x32_bf16 v[140:143], v[132:135], v[24:27], v[140:143]
v_perm_b32 v72, v44, v40, s44
v_perm_b32 v76, v44, v40, s45
v_perm_b32 v80, v45, v41, s44
v_perm_b32 v84, v45, v41, s45
v_perm_b32 v88, v46, v42, s44
v_perm_b32 v92, v46, v42, s45
v_perm_b32 v96, v47, v43, s44
v_perm_b32 v100, v47, v43, s45
s_waitcnt vmcnt(4)
buffer_load_dwordx4 v[40:43], v10, s[16:19], 0 offen offset:0 nt
v_cndmask_b32 v144, 0, v136, s[36:37]
v_cndmask_b32 v144, v144, v137, s[38:39]
v_cndmask_b32 v144, v144, v138, s[40:41]
v_cndmask_b32 v144, v144, v139, s[42:43]
s_nop 1
v_mfma_f32_16x16x4_f32 v[140:143], v144, v32, v[140:143]
s_waitcnt vmcnt(4)
buffer_load_dwordx4 v[44:47], v10, s[16:19], 0 offen offset:1024 nt
v_perm_b32 v73, v52, v48, s44
v_perm_b32 v77, v52, v48, s45
v_perm_b32 v81, v53, v49, s44
v_perm_b32 v85, v53, v49, s45
v_perm_b32 v89, v54, v50, s44
v_perm_b32 v93, v54, v50, s45
v_perm_b32 v97, v55, v51, s44
v_perm_b32 v101, v55, v51, s45
v_fma_f32 v140, v140, s46, v33
v_fma_f32 v141, v141, s46, v33
v_fma_f32 v142, v142, s46, v33
v_fma_f32 v143, v143, s46, v33
v_exp_f32 v140, v140
v_exp_f32 v141, v141
v_exp_f32 v142, v142
v_exp_f32 v143, v143
v_add_f32 v140, 0x358637bd, v140
v_add_f32 v141, 0x358637bd, v141
v_add_f32 v142, 0x358637bd, v142
v_add_f32 v143, 0x358637bd, v143
v_cvt_pk_bf16_f32 v150, v140, v141
v_cvt_pk_bf16_f32 v151, v142, v143
s_waitcnt vmcnt(4)
buffer_load_dwordx4 v[48:51], v10, s[16:19], 0 offen offset:2048 nt
ds_write_b128 v38, v[148:151]
v_add_u32 v38, 1024, v38
v_subrev_u32 v38, 16384, v38
v_mfma_f32_16x16x32_bf16 v[224:227], v[148:151], v[28:31], v[224:227]
s_waitcnt vmcnt(4)
buffer_load_dwordx4 v[52:55], v10, s[16:19], 0 offen offset:3072 nt
ds_read_b128 v[152:155], v38
v_add_u32 v38, 1024, v38
v_perm_b32 v74, v60, v56, s44
v_perm_b32 v78, v60, v56, s45
v_perm_b32 v82, v61, v57, s44
v_perm_b32 v86, v61, v57, s45
v_perm_b32 v90, v62, v58, s44
v_perm_b32 v94, v62, v58, s45
v_perm_b32 v98, v63, v59, s44
v_perm_b32 v102, v63, v59, s45
s_waitcnt vmcnt(4)
buffer_load_dwordx4 v[56:59], v10, s[16:19], s50 offen offset:0 nt
s_waitcnt lgkmcnt(0)
s_mov_b32 exec_hi, 0
ds_write_b128 v5, v[224:227] offset:4352
s_mov_b32 exec_hi, -1
s_waitcnt vmcnt(4)
buffer_load_dwordx4 v[60:63], v10, s[16:19], s50 offen offset:1024 nt
v_perm_b32 v75, v68, v64, s44
v_perm_b32 v79, v68, v64, s45
v_perm_b32 v83, v69, v65, s44
v_mfma_f32_16x16x32_bf16 v[192:195], v[152:155], v[72:75], v[192:195]
v_perm_b32 v87, v69, v65, s45
v_perm_b32 v91, v70, v66, s44
v_mfma_f32_16x16x32_bf16 v[196:199], v[152:155], v[76:79], v[196:199]
v_perm_b32 v95, v70, v66, s45
v_perm_b32 v99, v71, v67, s44
v_mfma_f32_16x16x32_bf16 v[200:203], v[152:155], v[80:83], v[200:203]
v_perm_b32 v103, v71, v67, s45
v_mfma_f32_16x16x32_bf16 v[204:207], v[152:155], v[84:87], v[204:207]
s_mov_b32 s48, 13
s_mov_b64 vcc, 0
L_vloop:
s_cbranch_vccnz L_deep0
s_waitcnt vmcnt(4)
L_deep0:
s_waitcnt vmcnt(5)
buffer_load_dwordx4 v[64:67], v10, s[16:19], s50 offen offset:2048 nt
v_mfma_f32_16x16x32_bf16 v[208:211], v[152:155], v[88:91], v[208:211]
v_mfma_f32_16x16x32_bf16 v[212:215], v[152:155], v[92:95], v[212:215]
v_mfma_f32_16x16x32_bf16 v[216:219], v[152:155], v[96:99], v[216:219]
v_mfma_f32_16x16x32_bf16 v[220:223], v[152:155], v[100:103], v[220:223]
s_cbranch_vccnz L_deep1
s_waitcnt vmcnt(4)
L_deep1:
s_waitcnt vmcnt(5)
buffer_load_dwordx4 v[68:71], v10, s[16:19], s50 offen offset:3072 nt
s_cmp_eq_u32 s48, 7
s_cselect_b32 s3, 0xfff94000, s58
v_add_u32 v10, s3, v10
v_perm_b32 v72, v44, v40, s44
v_perm_b32 v76, v44, v40, s45
v_perm_b32 v80, v45, v41, s44
v_perm_b32 v84, v45, v41, s45
v_perm_b32 v88, v46, v42, s44
v_perm_b32 v92, v46, v42, s45
v_perm_b32 v96, v47, v43, s44
v_perm_b32 v100, v47, v43, s45
s_cbranch_vccnz L_deep2
s_waitcnt vmcnt(4)
L_deep2:
s_waitcnt vmcnt(5)
buffer_load_dwordx4 v[40:43], v10, s[16:19], 0 offen offset:0 nt
ds_read_b128 v[152:155], v38
v_add_u32 v38, 1024, v38
s_cmp_lg_u32 s48, 9
s_cbranch_scc1 L_nobar
s_barrier
L_nobar:
s_cbranch_vccnz L_deep3
s_waitcnt vmcnt(4)
L_deep3:
s_waitcnt vmcnt(5)
buffer_load_dwordx4 v[44:47], v10, s[16:19], 0 offen offset:1024 nt
v_perm_b32 v73, v52, v48, s44
v_perm_b32 v77, v52, v48, s45
v_perm_b32 v81, v53, v49, s44
v_perm_b32 v85, v53, v49, s45
v_perm_b32 v89, v54, v50, s44
v_perm_b32 v93, v54, v50, s45
v_perm_b32 v97, v55, v51, s44
v_perm_b32 v101, v55, v51, s45
s_cbranch_vccnz L_deep4
s_waitcnt vmcnt(4)
L_deep4:
s_waitcnt vmcnt(5)
buffer_load_dwordx4 v[48:51], v10, s[16:19], 0 offen offset:2048 nt
s_cmp_eq_u32 s48, s49
s_cbranch_scc1 L_q
L_qret:
s_cbranch_vccnz L_deep5
s_waitcnt vmcnt(4)
L_deep5:
s_waitcnt vmcnt(5)
buffer_load_dwordx4 v[52:55], v10, s[16:19], 0 offen offset:3072 nt
v_perm_b32 v74, v60, v56, s44
v_perm_b32 v78, v60, v56, s45
v_perm_b32 v82, v61, v57, s44
v_perm_b32 v86, v61, v57, s45
v_perm_b32 v90, v62, v58, s44
v_perm_b32 v94, v62, v58, s45
v_perm_b32 v98, v63, v59, s44
v_perm_b32 v102, v63, v59, s45
s_cbranch_vccnz L_deep6
s_waitcnt vmcnt(4)
L_deep6:
s_waitcnt vmcnt(5)
buffer_load_dwordx4 v[56:59], v10, s[16:19], s50 offen offset:0 nt
s_cmp_eq_u32 s48, s57
s_cbranch_scc1 L_w
L_wret:
s_waitcnt lgkmcnt(0)
s_cbranch_vccnz L_deep7
s_waitcnt vmcnt(4)
L_deep7:
s_waitcnt vmcnt(5)
buffer_load_dwordx4 v[60:63], v10, s[16:19], s50 offen offset:1024 nt
v_perm_b32 v75, v68, v64, s44
v_perm_b32 v79, v68, v64, s45
v_perm_b32 v83, v69, v65, s44
v_mfma_f32_16x16x32_bf16 v[192:195], v[152:155], v[72:75], v[192:195]
v_perm_b32 v87, v69, v65, s45
v_perm_b32 v91, v70, v66, s44
v_mfma_f32_16x16x32_bf16 v[196:199], v[152:155], v[76:79], v[196:199]
v_perm_b32 v95, v70, v66, s45
v_perm_b32 v99, v71, v67, s44
v_mfma_f32_16x16x32_bf16 v[200:203], v[152:155], v[80:83], v[200:203]
v_perm_b32 v103, v71, v67, s45
v_mfma_f32_16x16x32_bf16 v[204:207], v[152:155], v[84:87], v[204:207]
s_sub_u32 s48, s48, 1
s_cmp_le_u32 s48, 5
s_cselect_b64 vcc, -1, 0
s_cmp_lg_u32 s48, 0
s_cbranch_scc1 L_vloop
s_waitcnt vmcnt(5)
buffer_load_dwordx4 v[64:67], v10, s[16:19], s50 offen offset:2048 nt
v_mfma_f32_16x16x32_bf16 v[208:211], v[152:155], v[88:91], v[208:211]
v_mfma_f32_16x16x32_bf16 v[212:215], v[152:155], v[92:95], v[212:215]
v_mfma_f32_16x16x32_bf16 v[216:219], v[152:155], v[96:99], v[216:219]
v_mfma_f32_16x16x32_bf16 v[220:223], v[152:155], v[100:103], v[220:223]
s_waitcnt vmcnt(5)
buffer_load_dwordx4 v[68:71], v10, s[16:19], s50 offen offset:3072 nt
v_perm_b32 v72, v44, v40, s44
v_perm_b32 v76, v44, v40, s45
v_perm_b32 v80, v45, v41, s44
v_perm_b32 v84, v45, v41, s45
v_perm_b32 v88, v46, v42, s44
v_perm_b32 v92, v46, v42, s45
v_perm_b32 v96, v47, v43, s44
v_perm_b32 v100, v47, v43, s45
s_waitcnt vmcnt(5)
buffer_load_dword v40, v39, s[16:19], 0 offen offset:0 nt
buffer_load_dword v41, v39, s[16:19], 0 offen offset:1024 nt
buffer_load_dword v42, v39, s[16:19], 0 offen offset:2048 nt
buffer_load_dword v43, v39, s[16:19], 0 offen offset:3072 nt
ds_read_b128 v[152:155], v38
v_add_u32 v38, 1024, v38
s_waitcnt vmcnt(8)
buffer_load_dword v44, v39, s[16:19], s50 offen offset:0 nt
buffer_load_dword v45, v39, s[16:19], s50 offen offset:1024 nt
buffer_load_dword v46, v39, s[16:19], s50 offen offset:2048 nt
buffer_load_dword v47, v39, s[16:19], s50 offen offset:3072 nt
v_perm_b32 v73, v52, v48, s44
v_perm_b32 v77, v52, v48, s45
v_perm_b32 v81, v53, v49, s44
v_perm_b32 v85, v53, v49, s45
v_perm_b32 v89, v54, v50, s44
v_perm_b32 v93, v54, v50, s45
v_perm_b32 v97, v55, v51, s44
v_perm_b32 v101, v55, v51, s45
s_waitcnt vmcnt(11)
buffer_load_dword v48, v39, s[16:19], s51 offen offset:0 nt
buffer_load_dword v49, v39, s[16:19], s51 offen offset:1024 nt
buffer_load_dword v50, v39, s[16:19], s51 offen offset:2048 nt
buffer_load_dword v51, v39, s[16:19], s51 offen offset:3072 nt
s_waitcnt vmcnt(14)
buffer_load_dword v52, v39, s[16:19], s52 offen offset:0 nt
buffer_load_dword v53, v39, s[16:19], s52 offen offset:1024 nt
buffer_load_dword v54, v39, s[16:19], s52 offen offset:2048 nt
buffer_load_dword v55, v39, s[16:19], s52 offen offset:3072 nt
v_perm_b32 v74, v60, v56, s44
v_perm_b32 v78, v60, v56, s45
v_perm_b32 v82, v61, v57, s44
v_perm_b32 v86, v61, v57, s45
v_perm_b32 v90, v62, v58, s44
v_perm_b32 v94, v62, v58, s45
v_perm_b32 v98, v63, v59, s44
v_perm_b32 v102, v63, v59, s45
s_waitcnt vmcnt(17)
buffer_load_dword v56, v39, s[16:19], s53 offen offset:0 nt
buffer_load_dword v57, v39, s[16:19], s53 offen offset:1024 nt
buffer_load_dword v58, v39, s[16:19], s53 offen offset:2048 nt
buffer_load_dword v59, v39, s[16:19], s53 offen offset:3072 nt
s_waitcnt lgkmcnt(0)
s_waitcnt vmcnt(20)
buffer_load_dword v60, v39, s[16:19], s54 offen offset:0 nt
buffer_load_dword v61, v39, s[16:19], s54 offen offset:1024 nt
buffer_load_dword v62, v39, s[16:19], s54 offen offset:2048 nt
buffer_load_dword v63, v39, s[16:19], s54 offen offset:3072 nt
v_perm_b32 v75, v68, v64, s44
v_perm_b32 v79, v68, v64, s45
v_perm_b32 v83, v69, v65, s44
v_mfma_f32_16x16x32_bf16 v[192:195], v[152:155], v[72:75], v[192:195]
v_perm_b32 v87, v69, v65, s45
v_mfma_f32_16x16x32_bf16 v[196:199], v[152:155], v[76:79], v[196:199]
v_perm_b32 v91, v70, v66, s44
v_mfma_f32_16x16x32_bf16 v[200:203], v[152:155], v[80:83], v[200:203]
v_perm_b32 v95, v70, v66, s45
v_mfma_f32_16x16x32_bf16 v[204:207], v[152:155], v[84:87], v[204:207]
v_perm_b32 v99, v71, v67, s44
v_mfma_f32_16x16x32_bf16 v[208:211], v[152:155], v[88:91], v[208:211]
v_perm_b32 v103, v71, v67, s45
v_mfma_f32_16x16x32_bf16 v[212:215], v[152:155], v[92:95], v[212:215]
v_mfma_f32_16x16x32_bf16 v[216:219], v[152:155], v[96:99], v[216:219]
v_mfma_f32_16x16x32_bf16 v[220:223], v[152:155], v[100:103], v[220:223]
s_mov_b32 exec_hi, 0
s_nop 0
ds_write_b128 v5, v[192:195] offset:0
ds_write_b128 v5, v[196:199] offset:544
ds_write_b128 v5, v[200:203] offset:1088
ds_write_b128 v5, v[204:207] offset:1632
ds_write_b128 v5, v[208:211] offset:2176
ds_write_b128 v5, v[212:215] offset:2720
ds_write_b128 v5, v[216:219] offset:3264
ds_write_b128 v5, v[220:223] offset:3808
s_mov_b32 exec_hi, -1
s_waitcnt vmcnt(20)
buffer_load_dword v64, v39, s[16:19], s55 offen offset:0 nt
buffer_load_dword v65, v39, s[16:19], s55 offen offset:1024 nt
buffer_load_dword v66, v39, s[16:19], s55 offen offset:2048 nt
buffer_load_dword v67, v39, s[16:19], s55 offen offset:3072 nt
v_perm_b32 v72, v41, v40, s44
v_perm_b32 v73, v43, v42, s44
v_perm_b32 v76, v41, v40, s45
v_perm_b32 v77, v43, v42, s45
s_waitcnt vmcnt(20)
buffer_load_dword v68, v39, s[16:19], s56 offen offset:0 nt
buffer_load_dword v69, v39, s[16:19], s56 offen offset:1024 nt
buffer_load_dword v70, v39, s[16:19], s56 offen offset:2048 nt
buffer_load_dword v71, v39, s[16:19], s56 offen offset:3072 nt
v_perm_b32 v74, v45, v44, s44
v_perm_b32 v75, v47, v46, s44
v_perm_b32 v78, v45, v44, s45
v_perm_b32 v79, v47, v46, s45
s_waitcnt lgkmcnt(0)
s_barrier
ds_read_b128 v[192:195], v6 offset:0
ds_read_b128 v[196:199], v6 offset:4896
ds_read_b128 v[200:203], v6 offset:9792
ds_read_b128 v[204:207], v6 offset:14688
ds_read_b128 v[208:211], v6 offset:544
ds_read_b128 v[212:215], v6 offset:5440
ds_read_b128 v[216:219], v6 offset:10336
ds_read_b128 v[220:223], v6 offset:15232
s_waitcnt lgkmcnt(4)
v_pk_add_f32 v[192:193], v[192:193], v[196:197]
v_pk_add_f32 v[194:195], v[194:195], v[198:199]
v_pk_add_f32 v[200:201], v[200:201], v[204:205]
v_pk_add_f32 v[202:203], v[202:203], v[206:207]
v_pk_add_f32 v[180:181], v[192:193], v[200:201]
v_pk_add_f32 v[182:183], v[194:195], v[202:203]
s_waitcnt lgkmcnt(0)
v_pk_add_f32 v[208:209], v[208:209], v[212:213]
v_pk_add_f32 v[210:211], v[210:211], v[214:215]
v_pk_add_f32 v[216:217], v[216:217], v[220:221]
v_pk_add_f32 v[218:219], v[218:219], v[222:223]
v_pk_add_f32 v[184:185], v[208:209], v[216:217]
v_pk_add_f32 v[186:187], v[210:211], v[218:219]
s_waitcnt vmcnt(20)
v_perm_b32 v80, v49, v48, s44
v_perm_b32 v81, v51, v50, s44
v_perm_b32 v84, v49, v48, s45
v_perm_b32 v85, v51, v50, s45
s_waitcnt vmcnt(16)
v_perm_b32 v82, v53, v52, s44
v_perm_b32 v83, v55, v54, s44
v_perm_b32 v86, v53, v52, s45
v_perm_b32 v87, v55, v54, s45
s_nop 1
v_mfma_f32_16x16x32_bf16 v[180:183], v[164:167], v[72:75], v[180:183]
v_mfma_f32_16x16x32_bf16 v[184:187], v[164:167], v[76:79], v[184:187]
v_mfma_f32_16x16x32_bf16 v[180:183], v[168:171], v[80:83], v[180:183]
v_mfma_f32_16x16x32_bf16 v[184:187], v[168:171], v[84:87], v[184:187]
s_waitcnt vmcnt(12)
v_perm_b32 v88, v57, v56, s44
v_perm_b32 v89, v59, v58, s44
v_perm_b32 v92, v57, v56, s45
v_perm_b32 v93, v59, v58, s45
s_waitcnt vmcnt(8)
v_perm_b32 v90, v61, v60, s44
v_perm_b32 v91, v63, v62, s44
v_perm_b32 v94, v61, v60, s45
v_perm_b32 v95, v63, v62, s45
s_nop 1
v_mfma_f32_16x16x32_bf16 v[180:183], v[172:175], v[88:91], v[180:183]
v_mfma_f32_16x16x32_bf16 v[184:187], v[172:175], v[92:95], v[184:187]
s_waitcnt vmcnt(4)
v_perm_b32 v96, v65, v64, s44
v_perm_b32 v97, v67, v66, s44
v_perm_b32 v100, v65, v64, s45
v_perm_b32 v101, v67, v66, s45
s_waitcnt vmcnt(0)
v_perm_b32 v98, v69, v68, s44
v_perm_b32 v99, v71, v70, s44
v_perm_b32 v102, v69, v68, s45
v_perm_b32 v103, v71, v70, s45
s_nop 1
v_mfma_f32_16x16x32_bf16 v[180:183], v[176:179], v[96:99], v[180:183]
v_mfma_f32_16x16x32_bf16 v[184:187], v[176:179], v[100:103], v[184:187]
s_nop 6
v_cvt_pk_bf16_f32 v104, v180, v181
v_cvt_pk_bf16_f32 v105, v182, v183
v_cvt_pk_bf16_f32 v106, v184, v185
v_cvt_pk_bf16_f32 v107, v186, v187
s_nop 0
v_mfma_f32_16x16x16_bf16 v[192:195], v[104:105], v[34:35], 0
v_mfma_f32_16x16x16_bf16 v[196:199], v[106:107], v[34:35], 0
v_mfma_f32_16x16x16_bf16 v[200:203], v[104:105], v[36:37], 0
v_mfma_f32_16x16x16_bf16 v[204:207], v[106:107], v[36:37], 0
s_nop 5
v_cvt_pk_bf16_f32 v120, v192, v196
v_cvt_pk_bf16_f32 v121, v193, v197
v_cvt_pk_bf16_f32 v122, v194, v198
v_cvt_pk_bf16_f32 v123, v195, v199
buffer_store_dwordx4 v[120:123], v8, s[32:35], 0 offen
v_cvt_pk_bf16_f32 v124, v200, v204
v_cvt_pk_bf16_f32 v125, v201, v205
v_cvt_pk_bf16_f32 v126, v202, v206
v_cvt_pk_bf16_f32 v127, v203, v207
buffer_store_dwordx4 v[124:127], v9, s[32:35], 0 offen
L_end:
s_endpgm
L_q:
ds_read_b128 v[104:107], v188 offset:0
ds_read_b128 v[108:111], v188 offset:16
ds_read_b128 v[112:115], v188 offset:32
ds_read_b128 v[116:119], v188 offset:48
ds_read_b128 v[120:123], v188 offset:4352
ds_read_b128 v[124:127], v188 offset:4368
ds_read_b128 v[128:131], v188 offset:4384
ds_read_b128 v[132:135], v188 offset:4400
s_waitcnt lgkmcnt(4)
v_mfma_f32_16x16x32_bf16 v[136:139], v[104:107], v[104:107], 0
v_mfma_f32_16x16x32_bf16 v[136:139], v[108:111], v[108:111], v[136:139]
v_mfma_f32_16x16x32_bf16 v[136:139], v[112:115], v[112:115], v[136:139]
v_mfma_f32_16x16x32_bf16 v[136:139], v[116:119], v[116:119], v[136:139]
v_mfma_f32_16x16x32_bf16 v[140:143], v[12:15], v[104:107], 0
v_mfma_f32_16x16x32_bf16 v[140:143], v[16:19], v[108:111], v[140:143]
v_mfma_f32_16x16x32_bf16 v[140:143], v[20:23], v[112:115], v[140:143]
v_mfma_f32_16x16x32_bf16 v[140:143], v[24:27], v[116:119], v[140:143]
s_nop 3
v_cndmask_b32 v144, 0, v136, s[36:37]
v_cndmask_b32 v144, v144, v137, s[38:39]
v_cndmask_b32 v144, v144, v138, s[40:41]
v_cndmask_b32 v144, v144, v139, s[42:43]
s_nop 1
v_mfma_f32_16x16x4_f32 v[140:143], v32, v144, v[140:143]
s_nop 9
v_fma_f32 v140, v140, s46, v33
v_fma_f32 v141, v141, s46, v33
v_fma_f32 v142, v142, s46, v33
v_fma_f32 v143, v143, s46, v33
v_exp_f32 v140, v140
v_exp_f32 v141, v141
v_exp_f32 v142, v142
v_exp_f32 v143, v143
v_add_f32 v156, 0x358637bd, v140
v_add_f32 v157, 0x358637bd, v141
v_add_f32 v158, 0x358637bd, v142
v_add_f32 v159, 0x358637bd, v143
s_waitcnt lgkmcnt(0)
v_mfma_f32_16x16x32_bf16 v[136:139], v[120:123], v[120:123], 0
v_mfma_f32_16x16x32_bf16 v[136:139], v[124:127], v[124:127], v[136:139]
v_mfma_f32_16x16x32_bf16 v[136:139], v[128:131], v[128:131], v[136:139]
v_mfma_f32_16x16x32_bf16 v[136:139], v[132:135], v[132:135], v[136:139]
v_mfma_f32_16x16x32_bf16 v[140:143], v[12:15], v[120:123], 0
v_mfma_f32_16x16x32_bf16 v[140:143], v[16:19], v[124:127], v[140:143]
v_mfma_f32_16x16x32_bf16 v[140:143], v[20:23], v[128:131], v[140:143]
v_mfma_f32_16x16x32_bf16 v[140:143], v[24:27], v[132:135], v[140:143]
s_nop 3
v_cndmask_b32 v144, 0, v136, s[36:37]
v_cndmask_b32 v144, v144, v137, s[38:39]
v_cndmask_b32 v144, v144, v138, s[40:41]
v_cndmask_b32 v144, v144, v139, s[42:43]
s_nop 1
v_mfma_f32_16x16x4_f32 v[140:143], v32, v144, v[140:143]
s_nop 9
v_fma_f32 v140, v140, s46, v33
v_fma_f32 v141, v141, s46, v33
v_fma_f32 v142, v142, s46, v33
v_fma_f32 v143, v143, s46, v33
v_exp_f32 v140, v140
v_exp_f32 v141, v141
v_exp_f32 v142, v142
v_exp_f32 v143, v143
v_add_f32 v160, 0x358637bd, v140
v_add_f32 v161, 0x358637bd, v141
v_add_f32 v162, 0x358637bd, v142
v_add_f32 v163, 0x358637bd, v143
s_branch L_qret
L_w:
ds_read_b128 v[104:107], v7 offset:4352
ds_read_b128 v[108:111], v7 offset:9248
ds_read_b128 v[112:115], v7 offset:14144
ds_read_b128 v[116:119], v7 offset:19040
ds_read_b128 v[164:167], v189 offset:0
ds_read_b128 v[168:171], v189 offset:17408
ds_read_b128 v[172:175], v189 offset:34816
ds_read_b128 v[176:179], v189 offset:52224
s_waitcnt lgkmcnt(4)
v_add_f32 v104, v104, v108
v_add_f32 v105, v105, v109
v_add_f32 v106, v106, v110
v_add_f32 v107, v107, v111
v_add_f32 v112, v112, v116
v_add_f32 v113, v113, v117
v_add_f32 v114, v114, v118
v_add_f32 v115, v115, v119
v_add_f32 v104, v104, v112
v_add_f32 v105, v105, v113
v_add_f32 v106, v106, v114
v_add_f32 v107, v107, v115
v_mul_f32 v120, v156, v104
v_mul_f32 v121, v160, v104
v_fmac_f32 v120, v157, v105
v_fmac_f32 v121, v161, v105
v_fmac_f32 v120, v158, v106
v_fmac_f32 v121, v162, v106
v_fmac_f32 v120, v159, v107
v_fmac_f32 v121, v163, v107
v_mov_b32 v122, v120
v_mov_b32 v123, v121
s_nop 1
v_permlane16_swap_b32 v120, v122
v_permlane16_swap_b32 v121, v123
s_nop 1
v_add_f32 v120, v120, v122
v_add_f32 v121, v121, v123
v_add_f32 v120, 0x358637bd, v120
v_add_f32 v121, 0x358637bd, v121
v_rcp_f32 v120, v120
v_rcp_f32 v121, v121
s_mov_b32 s78, 0
s_mov_b32 s79, -1
v_mul_f32 v156, v156, v120
v_mul_f32 v157, v157, v120
v_mul_f32 v158, v158, v120
v_mul_f32 v159, v159, v120
v_mul_f32 v160, v160, v121
v_mul_f32 v161, v161, v121
v_mul_f32 v162, v162, v121
v_mul_f32 v163, v163, v121
v_cvt_pk_bf16_f32 v132, v156, v157
v_cvt_pk_bf16_f32 v133, v158, v159
v_cvt_pk_bf16_f32 v134, v160, v161
v_cvt_pk_bf16_f32 v135, v162, v163
v_lshlrev_b32 v124, 16, v132
v_lshlrev_b32 v125, 16, v133
v_lshlrev_b32 v126, 16, v134
v_lshlrev_b32 v127, 16, v135
v_and_b32 v128, 0xffff0000, v132
v_and_b32 v129, 0xffff0000, v133
v_and_b32 v130, 0xffff0000, v134
v_and_b32 v131, 0xffff0000, v135
v_sub_f32 v124, v156, v124
v_sub_f32 v125, v158, v125
v_sub_f32 v126, v160, v126
v_sub_f32 v127, v162, v127
v_sub_f32 v128, v157, v128
v_sub_f32 v129, v159, v129
v_sub_f32 v130, v161, v130
v_sub_f32 v131, v163, v131
v_cvt_pk_bf16_f32 v124, v124, v128
v_cvt_pk_bf16_f32 v125, v125, v129
v_cvt_pk_bf16_f32 v126, v126, v130
v_cvt_pk_bf16_f32 v127, v127, v131
v_cndmask_b32 v34, v132, v124, s[78:79]
v_cndmask_b32 v35, v133, v125, s[78:79]
v_cndmask_b32 v36, v134, v126, s[78:79]
v_cndmask_b32 v37, v135, v127, s[78:79]
s_branch L_wret
L_codeend:
.section .rodata,"a"
.p2align 6
.amdhsa_kernel standalone__linear_kernel_rfa__sampling_kernel
  .amdhsa_next_free_vgpr 232
  .amdhsa_next_free_sgpr 80
  .amdhsa_accum_offset 232
  .amdhsa_group_segment_fixed_size 0
  .amdhsa_kernarg_size 56
  .amdhsa_user_sgpr_count 2
  .amdhsa_user_sgpr_kernarg_segment_ptr 1
  .amdhsa_system_sgpr_workgroup_id_x 1
  .amdhsa_float_denorm_mode_32 3
.end_amdhsa_kernel
```
